```python
import torch

def _softmax(x, axis=-1):
    return torch.softmax(x, dim=axis)
def _gelu(x):
    return torch.nn.functional.gelu(x, approximate="tanh")
def _silu(x):
    return torch.nn.functional.silu(x)
def _sigmoid(x):
    return torch.sigmoid(x)
def _layernorm(x, axis=-1, eps=1e-5):
    m = x.mean(dim=axis, keepdim=True)
    v = x.var(dim=axis, keepdim=True, unbiased=False)
    return (x - m) / torch.sqrt(v + eps)
def _scatter_add(tgt, idx, src, axis=0):
    return tgt.clone().index_add_(axis, idx, src)
def _segment_sum(src, seg, n):
    out = torch.zeros((n,) + src.shape[1:], dtype=src.dtype)
    return out.index_add_(0, seg, src)
def _pad(x, pw):
    flat = tuple(v for pair in reversed(pw) for v in pair)
    return torch.nn.functional.pad(x, flat)

kernel_name = 'standalone__batchnorm__prompt'

def setup_inputs():

    _w = (lambda a: (lambda t: t.to(torch.bfloat16) if t.is_floating_point() else t)(torch.as_tensor(a)))
    B, S, C = 1, 2048, 1024
    K = 3
    return {
        "x": _w((lambda *s: torch.randn(*s, dtype=torch.bfloat16) * 0.05)(B, S, C)),
        "w": _w((lambda *s: torch.randn(*s, dtype=torch.bfloat16) * 0.05)(K, C, C) * (1.0 / (K * C) ** 0.5)),
        "mean": _w((lambda *s: torch.randn(*s, dtype=torch.bfloat16) * 0.05)(C) * 0.1),
        "var": _w(torch.abs((lambda *s: torch.randn(*s, dtype=torch.bfloat16) * 0.05)(C)) + 0.5),
        "g": _w((lambda *s: torch.randn(*s, dtype=torch.bfloat16) * 0.05)(C) + 1.0),
        "b": _w((lambda *s: torch.randn(*s, dtype=torch.bfloat16) * 0.05)(C) * 0.1),
    }

def reference(x, w, mean, var, g, b):
    K = 3
    P = K // 2
    S = x.shape[1]
    xp = _pad(x, ((0, 0), (P, P), (0, 0)))
    y = sum(torch.einsum('bsc,cd->bsd', xp[:, k:k + S, :], w[k]) for k in range(K))
    inv_std = 1.0 / torch.sqrt(var + 1e-5)
    y = (y - mean) * (g * inv_std) + b
    return _silu(y)
```

```asm
; @launch grid=(256,1,1) block=(512,1,1) lds=157952
.amdgcn_target "amdgcn-amd-amdhsa--gfx950"
.text
.globl standalone__batchnorm__prompt_kernel
.p2align 8
.type standalone__batchnorm__prompt_kernel,@function
standalone__batchnorm__prompt_kernel:
    s_load_dwordx16 s[36:51], s[0:1], 0
    v_readfirstlane_b32 s19, v0
    s_cmpk_ge_u32 s2, 0x100
    s_cbranch_scc1 L_end
    s_lshr_b32 s20, s2, 3
    s_and_b32 s21, s20, 7
    s_and_b32 s22, s2, 4
    s_lshl1_add_u32 s23, s22, s21
    s_andn2_b32 s24, 3, s2
    s_lshr_b32 s25, s2, 6
    s_lshl2_add_u32 s24, s25, s24
    s_lshl_b32 s23, s23, 18
    s_lshl_b32 s24, s24, 7
    s_getpc_b64 s[16:17]
L_pc:
    s_cmpk_ge_u32 s19, 0x100
    s_cbranch_scc0 L_load
    s_lshl_b32 s26, s20, 8
    s_add_u32 s26, s26, s19
    s_load_dword s3, s[16:17], s26
    s_waitcnt lgkmcnt(0)
    s_branch L_cons
L_load:
    v_bfe_u32 v2, v0, 3, 3
    v_and_b32 v3, 7, v0
    v_lshrrev_b32 v4, 1, v2
    v_xor_b32 v5, v3, v4
    s_lshl_b32 s12, s19, 6
    s_add_u32 s26, s12, s23
    v_lshl_add_u32 v5, v5, 4, s26
    v_lshl_add_u32 v5, v2, 14, v5
    s_bitcmp1_b32 s2, 7
    s_cselect_b32 s26, 0x20040, 0
    v_xor_b32 v5, s26, v5
    v_xor_b32 v6, 0x20040, v5
    s_lshr_b32 s26, s26, 7
    s_add_u32 s12, s12, s26
    v_and_b32 v4, 2, v2
    v_xor_b32 v7, v4, v3
    s_lshl_b32 s26, s19, 9
    s_add_u32 s26, s26, s24
    v_lshl_add_u32 v7, v7, 4, s26
    v_lshl_add_u32 v7, v2, 11, v7
    s_lshr_b32 s14, s19, 5
    s_bitcmp1_b32 s2, 5
    s_cselect_b32 s26, 0x4040, 0
    s_addc_u32 s14, s14, 0
    v_xor_b32 v7, s26, v7
    v_xor_b32 v8, 0x4040, v7
    s_xor_b32 s15, s14, 1
    s_mulk_i32 s14, 3072
    s_mulk_i32 s15, 3072
    s_addk_i32 s14, 16640
    s_addk_i32 s15, 16640
    v_mul_u32_u24 v9, 7, v2
    v_xor_b32 v9, v9, v3
    s_add_u32 s26, s23, 0x40000
    v_lshl_add_u32 v9, v9, 4, s26
    v_mul_u32_u24 v4, 0x40800, v2
    v_sub_u32 v9, v9, v4
    s_add_u32 s29, s21, s25
    s_and_b32 s29, s29, 3
    s_lshl2_add_u32 s26, s2, s22
    s_and_b32 s26, s26, 4
    s_or_b32 s29, s29, s26
    s_lshl_b32 s26, s29, 2
    s_lshr_b32 s31, 0x76765454, s26
    s_and_b32 s31, s31, 15
    s_lshl3_add_u32 s29, s29, L_tab-L_pc
    s_lshl_b32 s6, 1, 22
    s_lshl_b32 s7, 1, 17
    s_lshl_b32 s10, 3, 21
    s_mov_b32 s11, s7
    v_cmp_gt_u32 vcc, 64, v0
    v_and_b32 v16, 63, v0
    v_lshl_add_u32 v10, v16, 1, s24
    s_mov_b32 s30, 0
    s_mov_b32 s33, 0
    s_waitcnt lgkmcnt(0)
    s_load_dwordx2 s[54:55], s[16:17], s29
L_adv:
    s_lshl_b32 s32, s31, 17
    s_add_u32 m0, s33, s14
    s_mov_b64 s[8:9], s[38:39]
    buffer_load_dwordx4 v7, s[8:11], s32 offen offset:0 lds
    s_add_u32 s34, s32, 2096128
    s_lshl_b32 s31, s31, 7
    buffer_load_dwordx4 v7, s[8:11], s34 offen offset:1024 lds
    s_add_u32 s35, s32, 4192256
    s_mov_b64 s[4:5], s[36:37]
    buffer_load_dwordx4 v7, s[8:11], s35 offen offset:2048 lds
    s_cbranch_vccz L_nh
    s_add_u32 m0, s33, 16384
    s_mov_b64 exec, 0xffff
    buffer_load_dwordx4 v9, s[4:7], s31 offen lds
L_nh:
    s_add_u32 m0, s33, s12
    s_mov_b64 exec, -1
    buffer_load_dwordx4 v5, s[4:7], s31 offen offset:0 lds
    buffer_load_dwordx4 v5, s[4:7], s31 offen offset:2048 lds
    s_xor_b32 m0, m0, 0x400
    s_nop 0
    buffer_load_dwordx4 v6, s[4:7], s31 offen offset:0 lds
    buffer_load_dwordx4 v6, s[4:7], s31 offen offset:2048 lds
    s_add_u32 m0, s33, s15
    s_add_u32 s13, s33, 41216
    buffer_load_dwordx4 v8, s[8:11], s32 offen offset:0 lds
    s_cmp_ge_u32 s30, 1
    s_cbranch_scc0 L_nb8
    s_waitcnt vmcnt(9)
    s_cbranch_vccnz L_b8
    s_waitcnt vmcnt(8)
L_b8:
    s_barrier
L_nb8:
    buffer_load_dwordx4 v8, s[8:11], s34 offen offset:1024 lds
    buffer_load_dwordx4 v8, s[8:11], s35 offen offset:2048 lds
    s_bitcmp1_b32 s33, 16
    s_cselect_b32 s33, 0, s13
    s_add_u32 s30, s30, 1
    s_waitcnt lgkmcnt(0)
    s_and_b32 s31, s54, 15
    s_lshr_b64 s[54:55], s[54:55], 4
    s_cmp_lt_u32 s30, 16
    s_cbranch_scc1 L_adv
    s_mov_b32 s26, 0xbfb8aa3b
    s_cbranch_vccnz L_par
    s_waitcnt vmcnt(0)
    s_barrier
    s_branch L_ep
L_par:
    global_load_ushort v12, v10, s[40:41]
    global_load_ushort v13, v10, s[42:43]
    global_load_ushort v14, v10, s[44:45]
    global_load_ushort v15, v10, s[46:47]
    s_waitcnt vmcnt(4)
    s_barrier
    s_mov_b32 s26, 123648
    v_lshl_add_u32 v17, v16, 2, s26
    s_mov_b32 s26, 0xbfb8aa3b
    s_waitcnt vmcnt(0)
    v_lshlrev_b32 v13, 16, v13
    v_add_f32 v13, 0x3727c5ac, v13
    v_rsq_f32 v13, v13
    v_lshlrev_b32 v12, 16, v12
    v_lshlrev_b32 v14, 16, v14
    v_lshlrev_b32 v15, 16, v15
    v_mul_f32 v13, v13, v14
    v_fma_f32 v15, -v12, v13, v15
    v_mul_f32 v13, s26, v13
    v_mul_f32 v15, s26, v15
    ds_write_b32 v17, v13
    ds_write_b32 v17, v15 offset:256
    s_waitcnt lgkmcnt(0)
L_ep:
    s_barrier
    s_mov_b32 s27, 148736
    v_lshl_add_u32 v11, v0, 4, s27
    ds_read_b64 v[212:213], v11 offset:4096
    ds_read_b128 v[208:211], v11
    s_mov_b32 s50, 0x400000
    s_mov_b32 s51, 0x20000
    s_movk_i32 s27, 0x1000
    s_movk_i32 s28, 0x2000
    s_barrier
    s_waitcnt lgkmcnt(0)
    ds_read_b128 v[64:67], v212
    ds_read_b128 v[72:75], v212 offset:256
    ds_read_b128 v[68:71], v212 offset:16
    ds_read_b128 v[76:79], v212 offset:272
    s_barrier
    ds_read_b128 v[80:83], v208 offset:8192
    ds_read_b128 v[88:91], v210 offset:8192
    ds_read_b128 v[84:87], v209 offset:8192
    ds_read_b128 v[92:95], v211 offset:8192
    ds_read_b128 v[96:99], v208 offset:16384
    ds_read_b128 v[104:107], v210 offset:16384
    ds_read_b128 v[100:103], v209 offset:16384
    ds_read_b128 v[108:111], v211 offset:16384
    s_waitcnt lgkmcnt(0)
    v_pk_add_f32 v[80:81], v[80:81], v[88:89]
    v_pk_add_f32 v[82:83], v[82:83], v[90:91]
    v_pk_fma_f32 v[80:81], v[80:81], v[64:65], v[72:73]
    v_pk_add_f32 v[84:85], v[84:85], v[92:93]
    v_pk_fma_f32 v[82:83], v[82:83], v[66:67], v[74:75]
    v_exp_f32 v112, v80
    v_pk_add_f32 v[86:87], v[86:87], v[94:95]
    v_exp_f32 v113, v81
    v_pk_fma_f32 v[84:85], v[84:85], v[68:69], v[76:77]
    v_exp_f32 v114, v82
    v_pk_fma_f32 v[86:87], v[86:87], v[70:71], v[78:79]
    v_exp_f32 v115, v83
    v_pk_fma_f32 v[112:113], v[112:113], s[26:27], s[26:27] op_sel_hi:[1,0,0]
    v_exp_f32 v116, v84
    v_exp_f32 v117, v85
    v_pk_fma_f32 v[114:115], v[114:115], s[26:27], s[26:27] op_sel_hi:[1,0,0]
    v_exp_f32 v118, v86
    v_exp_f32 v119, v87
    v_pk_fma_f32 v[116:117], v[116:117], s[26:27], s[26:27] op_sel_hi:[1,0,0]
    v_rcp_f32 v112, v112
    v_rcp_f32 v113, v113
    v_pk_fma_f32 v[118:119], v[118:119], s[26:27], s[26:27] op_sel_hi:[1,0,0]
    v_rcp_f32 v114, v114
    v_rcp_f32 v115, v115
    v_pk_mul_f32 v[80:81], v[80:81], v[112:113]
    v_rcp_f32 v116, v116
    v_rcp_f32 v117, v117
    v_pk_mul_f32 v[82:83], v[82:83], v[114:115]
    v_rcp_f32 v118, v118
    v_cvt_pk_bf16_f32 v128, v80, v81
    v_rcp_f32 v119, v119
    v_pk_mul_f32 v[84:85], v[84:85], v[116:117]
    v_cvt_pk_bf16_f32 v129, v82, v83
    v_pk_mul_f32 v[86:87], v[86:87], v[118:119]
    v_cvt_pk_bf16_f32 v130, v84, v85
    v_cvt_pk_bf16_f32 v131, v86, v87
    buffer_store_dwordx4 v[128:131], v213, s[48:51], s27 offen sc0 sc1 nt
    v_pk_add_f32 v[96:97], v[96:97], v[104:105]
    v_pk_add_f32 v[98:99], v[98:99], v[106:107]
    v_pk_fma_f32 v[96:97], v[96:97], v[64:65], v[72:73]
    v_pk_add_f32 v[100:101], v[100:101], v[108:109]
    v_pk_fma_f32 v[98:99], v[98:99], v[66:67], v[74:75]
    v_exp_f32 v120, v96
    v_pk_add_f32 v[102:103], v[102:103], v[110:111]
    v_exp_f32 v121, v97
    v_pk_fma_f32 v[100:101], v[100:101], v[68:69], v[76:77]
    v_exp_f32 v122, v98
    v_pk_fma_f32 v[102:103], v[102:103], v[70:71], v[78:79]
    v_exp_f32 v123, v99
    v_pk_fma_f32 v[120:121], v[120:121], s[26:27], s[26:27] op_sel_hi:[1,0,0]
    v_exp_f32 v124, v100
    v_exp_f32 v125, v101
    v_pk_fma_f32 v[122:123], v[122:123], s[26:27], s[26:27] op_sel_hi:[1,0,0]
    v_exp_f32 v126, v102
    v_exp_f32 v127, v103
    v_pk_fma_f32 v[124:125], v[124:125], s[26:27], s[26:27] op_sel_hi:[1,0,0]
    v_rcp_f32 v120, v120
    v_rcp_f32 v121, v121
    v_pk_fma_f32 v[126:127], v[126:127], s[26:27], s[26:27] op_sel_hi:[1,0,0]
    v_rcp_f32 v122, v122
    v_rcp_f32 v123, v123
    v_pk_mul_f32 v[96:97], v[96:97], v[120:121]
    v_rcp_f32 v124, v124
    v_rcp_f32 v125, v125
    v_pk_mul_f32 v[98:99], v[98:99], v[122:123]
    v_rcp_f32 v126, v126
    v_cvt_pk_bf16_f32 v132, v96, v97
    v_rcp_f32 v127, v127
    v_pk_mul_f32 v[100:101], v[100:101], v[124:125]
    v_cvt_pk_bf16_f32 v133, v98, v99
    v_pk_mul_f32 v[102:103], v[102:103], v[126:127]
    v_cvt_pk_bf16_f32 v134, v100, v101
    v_cvt_pk_bf16_f32 v135, v102, v103
    buffer_store_dwordx4 v[132:135], v213, s[48:51], s28 offen sc0 sc1 nt
L_end:
    s_endpgm
    .fill (((32 - ((. - standalone__batchnorm__prompt_kernel + L_cloop - L_cons) & 31)) & 31) / 4), 4, 0xbf810000
L_cons:
    s_bitcmp1_b32 s19, 6
    s_cselect_b64 s[4:5], s[42:43], s[40:41]
    s_cselect_b64 s[6:7], s[46:47], s[44:45]
    s_bitcmp1_b32 s19, 7
    s_cselect_b64 s[4:5], s[6:7], s[4:5]
    s_load_dword s3, s[4:5], s24
    s_load_dword s3, s[4:5], s24 offset:64
    v_and_b32 v10, 15, v0
    v_bfe_u32 v11, v0, 4, 2
    v_lshrrev_b32 v1, 2, v10
    v_lshrrev_b32 v2, 3, v10
    v_xor_b32 v1, v1, v2
    v_and_b32 v1, 1, v1
    v_and_b32 v2, 3, v10
    v_lshl_add_u32 v1, v2, 1, v1
    v_and_or_b32 v1, v10, 8, v1
    v_bfe_u32 v12, v0, 7, 1
    v_bfe_u32 v13, v0, 6, 1
    v_lshl_add_u32 v2, v12, 2, v11
    v_lshrrev_b32 v4, 1, v1
    v_xor_b32 v4, v4, v2
    v_lshlrev_b32 v4, 4, v4
    v_lshl_add_u32 v193, v1, 7, v4
    v_add_u32 v3, -1, v1
    v_bfe_u32 v4, v3, 1, 3
    v_xor_b32 v4, v4, v2
    v_lshlrev_b32 v4, 4, v4
    v_ashrrev_i32 v5, 31, v3
    v_and_b32 v5, 18, v5
    v_add_u32 v3, 0x70, v3
    v_add_u32 v3, v3, v5
    v_lshl_add_u32 v192, v3, 7, v4
    v_add_u32 v3, 1, v1
    v_bfe_u32 v4, v3, 1, 3
    v_xor_b32 v4, v4, v2
    v_lshlrev_b32 v4, 4, v4
    v_and_b32 v5, 16, v3
    v_and_b32 v3, 15, v3
    v_lshl_add_u32 v3, v5, 3, v3
    v_lshl_add_u32 v194, v3, 7, v4
    v_mul_u32_u24 v2, 3072, v2
    v_bfe_u32 v4, v0, 2, 2
    v_lshl_add_u32 v2, v4, 7, v2
    v_and_b32 v5, 3, v0
    v_lshl_add_u32 v2, v5, 3, v2
    v_and_b32 v3, 1, v11
    v_xor_b32 v3, v3, v13
    v_lshrrev_b32 v4, 1, v4
    v_lshl_add_u32 v3, v3, 1, v4
    v_lshl_add_u32 v2, v3, 5, v2
    v_add_u32 v195, 16640, v2
    v_xor_b32 v196, 32, v195
    v_lshl_add_u32 v2, v13, 3, v11
    v_and_b32 v3, 7, v10
    v_xor_b32 v2, v2, v3
    v_lshlrev_b32 v2, 4, v2
    v_lshl_add_u32 v2, v10, 8, v2
    v_mul_u32_u24 v3, 82944, v12
    v_add_u32 v2, v2, v3
    v_add_u32 v197, 41216, v2
    v_xor_b32 v198, 64, v197
    v_lshlrev_b32 v2, 2, v0
    v_add_u32 v204, 155904, v2
    v_mov_b32 v205, 1
    v_and_b32 v4, 3, v0
    v_mul_u32_u24 v4, 0x104, v4
    v_add_u32 v214, 156928, v4
    v_bfe_u32 v2, v0, 3, 3
    v_and_b32 v3, 7, v0
    v_lshlrev_b32 v4, 1, v3
    v_xor_b32 v4, v4, v2
    s_and_b32 s26, s19, 0xc0
    s_lshl_b32 s26, s26, 5
    s_add_u32 s26, s26, 41216
    v_lshl_add_u32 v4, v4, 4, s26
    v_lshl_add_u32 v208, v2, 8, v4
    v_xor_b32 v209, 16, v208
    v_add_u32 v210, 82944, v208
    v_add_u32 v211, 82944, v209
    v_lshlrev_b32 v4, 5, v3
    v_add_u32 v212, 123648, v4
    v_and_b32 v4, 3, v2
    v_lshrrev_b32 v1, 2, v2
    v_lshl_add_u32 v1, v4, 1, v1
    s_bitcmp1_b32 s19, 6
    s_cselect_b32 s27, 9, 0
    v_xor_b32 v1, s27, v1
    s_and_b32 s26, s19, 0x80
    s_lshl_b32 s26, s26, 4
    s_add_u32 s26, s26, s23
    s_add_u32 s26, s26, s24
    v_lshl_add_u32 v4, v3, 4, s26
    v_lshl_add_u32 v213, v1, 14, v4
    s_mov_b32 s50, 0x400000
    s_mov_b32 s51, 0x20000
    s_mov_b32 s26, 0xbfb8aa3b
    s_movk_i32 s29, 0x3000
    v_lshlrev_b32 v4, 4, v0
    v_add_u32 v4, 144640, v4
    ds_write_b128 v4, v[208:211]
    ds_write_b64 v4, v[212:213] offset:4096
    v_mov_b32 v199, v192
    v_mov_b32 v200, v193
    v_mov_b32 v201, v194
    v_mov_b32 v202, v195
    v_mov_b32 v203, v196
    v_mov_b64 v[0:1], 0
    v_mov_b64 v[2:3], 0
    v_mov_b64 v[4:5], 0
    v_mov_b64 v[6:7], 0
    v_mov_b64 v[8:9], 0
    v_mov_b64 v[10:11], 0
    v_mov_b64 v[12:13], 0
    v_mov_b64 v[14:15], 0
    v_mov_b64 v[16:17], 0
    v_mov_b64 v[18:19], 0
    v_mov_b64 v[20:21], 0
    v_mov_b64 v[22:23], 0
    v_mov_b64 v[24:25], 0
    v_mov_b64 v[26:27], 0
    v_mov_b64 v[28:29], 0
    v_mov_b64 v[30:31], 0
    v_mov_b64 v[32:33], 0
    v_mov_b64 v[34:35], 0
    v_mov_b64 v[36:37], 0
    v_mov_b64 v[38:39], 0
    v_mov_b64 v[40:41], 0
    v_mov_b64 v[42:43], 0
    v_mov_b64 v[44:45], 0
    v_mov_b64 v[46:47], 0
    v_mov_b64 v[48:49], 0
    v_mov_b64 v[50:51], 0
    v_mov_b64 v[52:53], 0
    v_mov_b64 v[54:55], 0
    v_mov_b64 v[56:57], 0
    v_mov_b64 v[58:59], 0
    v_mov_b64 v[60:61], 0
    v_mov_b64 v[62:63], 0
    ds_write_b32 v204, v0
    s_mov_b32 s30, 0
    s_mov_b32 s33, 0
    s_mov_b32 s35, 41216
    s_setprio 3
    s_barrier
    ds_read_b64_tr_b16 v[104:105], v195 offset:0
    ds_read_b64_tr_b16 v[106:107], v195 offset:512
    ds_read_b128 v[64:67], v192 offset:0
    ds_read_b64_tr_b16 v[112:113], v195 offset:1024
    ds_read_b64_tr_b16 v[114:115], v195 offset:1536
    ds_read_b128 v[68:71], v193 offset:0
    ds_read_b64_tr_b16 v[120:121], v195 offset:2048
    ds_read_b64_tr_b16 v[122:123], v195 offset:2560
    ds_read_b128 v[72:75], v193 offset:2048
    ds_read_b128 v[76:79], v193 offset:4096
    ds_read_b128 v[80:83], v193 offset:6144
    ds_read_b128 v[84:87], v193 offset:8192
    ds_read_b64_tr_b16 v[108:109], v196 offset:0
    ds_read_b64_tr_b16 v[110:111], v196 offset:512
    ds_read_b64_tr_b16 v[116:117], v196 offset:1024
    ds_read_b64_tr_b16 v[118:119], v196 offset:1536
    s_waitcnt lgkmcnt(7)
L_cloop:
    v_mfma_f32_16x16x32_bf16 v[0:3], v[104:107], v[64:67], v[0:3]
    ds_read_b64_tr_b16 v[124:125], v196 offset:2048
    v_mfma_f32_16x16x32_bf16 v[0:3], v[112:115], v[68:71], v[0:3]
    ds_read_b64_tr_b16 v[126:127], v196 offset:2560
    v_mfma_f32_16x16x32_bf16 v[0:3], v[120:123], v[72:75], v[0:3]
    s_waitcnt lgkmcnt(6)
    v_mfma_f32_16x16x32_bf16 v[8:11], v[120:123], v[76:79], v[8:11]
    ds_read_b128 v[88:91], v193 offset:10240
    v_mfma_f32_16x16x32_bf16 v[8:11], v[112:115], v[72:75], v[8:11]
    ds_read_b128 v[92:95], v193 offset:12288
    v_mfma_f32_16x16x32_bf16 v[8:11], v[104:107], v[68:71], v[8:11]
    ds_read_b128 v[96:99], v193 offset:14336
    v_mfma_f32_16x16x32_bf16 v[16:19], v[104:107], v[72:75], v[16:19]
    ds_read_b128 v[100:103], v194 offset:0
    v_mfma_f32_16x16x32_bf16 v[16:19], v[112:115], v[76:79], v[16:19]
    s_add_u32 s33, s33, 1
    v_mfma_f32_16x16x32_bf16 v[16:19], v[120:123], v[80:83], v[16:19]
    s_cmp_eq_u32 s33, 3
    v_mfma_f32_16x16x32_bf16 v[24:27], v[120:123], v[84:87], v[24:27]
    s_cselect_b32 s34, 0xfffebe00, s35
    v_mfma_f32_16x16x32_bf16 v[24:27], v[112:115], v[80:83], v[24:27]
    s_waitcnt lgkmcnt(4)
    v_mfma_f32_16x16x32_bf16 v[24:27], v[104:107], v[76:79], v[24:27]
    s_cselect_b32 s33, 0, s33
    v_mfma_f32_16x16x32_bf16 v[4:7], v[108:111], v[64:67], v[4:7]
    v_add_u32 v192, s34, v192
    v_mfma_f32_16x16x32_bf16 v[4:7], v[116:119], v[68:71], v[4:7]
    v_add_u32 v193, s34, v193
    v_mfma_f32_16x16x32_bf16 v[4:7], v[124:127], v[72:75], v[4:7]
    v_add_u32 v194, s34, v194
    v_mfma_f32_16x16x32_bf16 v[12:15], v[124:127], v[76:79], v[12:15]
    v_add_u32 v195, s34, v195
    v_mfma_f32_16x16x32_bf16 v[12:15], v[116:119], v[72:75], v[12:15]
    v_add_u32 v196, s34, v196
    v_mfma_f32_16x16x32_bf16 v[12:15], v[108:111], v[68:71], v[12:15]
    v_mfma_f32_16x16x32_bf16 v[20:23], v[108:111], v[72:75], v[20:23]
    v_mfma_f32_16x16x32_bf16 v[20:23], v[116:119], v[76:79], v[20:23]
    v_mfma_f32_16x16x32_bf16 v[20:23], v[124:127], v[80:83], v[20:23]
    v_mfma_f32_16x16x32_bf16 v[28:31], v[124:127], v[84:87], v[28:31]
    v_mfma_f32_16x16x32_bf16 v[28:31], v[116:119], v[80:83], v[28:31]
    v_mfma_f32_16x16x32_bf16 v[28:31], v[108:111], v[76:79], v[28:31]
    s_waitcnt lgkmcnt(0)
    v_mfma_f32_16x16x32_bf16 v[36:39], v[108:111], v[80:83], v[36:39]
    v_mfma_f32_16x16x32_bf16 v[36:39], v[116:119], v[84:87], v[36:39]
    v_mfma_f32_16x16x32_bf16 v[36:39], v[124:127], v[88:91], v[36:39]
    v_mfma_f32_16x16x32_bf16 v[44:47], v[124:127], v[92:95], v[44:47]
    v_mfma_f32_16x16x32_bf16 v[44:47], v[116:119], v[88:91], v[44:47]
    v_mfma_f32_16x16x32_bf16 v[44:47], v[108:111], v[84:87], v[44:47]
    s_barrier
    v_mfma_f32_16x16x32_bf16 v[52:55], v[108:111], v[88:91], v[52:55]
    ds_read_b64_tr_b16 v[168:169], v195 offset:0
    v_mfma_f32_16x16x32_bf16 v[52:55], v[116:119], v[92:95], v[52:55]
    ds_read_b64_tr_b16 v[170:171], v195 offset:512
    v_mfma_f32_16x16x32_bf16 v[52:55], v[124:127], v[96:99], v[52:55]
    ds_read_b128 v[128:131], v192 offset:0
    v_mfma_f32_16x16x32_bf16 v[60:63], v[124:127], v[100:103], v[60:63]
    ds_read_b64_tr_b16 v[176:177], v195 offset:1024
    v_mfma_f32_16x16x32_bf16 v[60:63], v[116:119], v[96:99], v[60:63]
    ds_read_b64_tr_b16 v[178:179], v195 offset:1536
    v_mfma_f32_16x16x32_bf16 v[60:63], v[108:111], v[92:95], v[60:63]
    ds_read_b128 v[132:135], v193 offset:0
    v_mfma_f32_16x16x32_bf16 v[32:35], v[104:107], v[80:83], v[32:35]
    ds_read_b64_tr_b16 v[184:185], v195 offset:2048
    v_mfma_f32_16x16x32_bf16 v[32:35], v[112:115], v[84:87], v[32:35]
    ds_read_b64_tr_b16 v[186:187], v195 offset:2560
    v_mfma_f32_16x16x32_bf16 v[32:35], v[120:123], v[88:91], v[32:35]
    ds_read_b128 v[136:139], v193 offset:2048
    v_mfma_f32_16x16x32_bf16 v[40:43], v[120:123], v[92:95], v[40:43]
    ds_read_b128 v[140:143], v193 offset:4096
    v_mfma_f32_16x16x32_bf16 v[40:43], v[112:115], v[88:91], v[40:43]
    ds_read_b128 v[144:147], v193 offset:6144
    v_mfma_f32_16x16x32_bf16 v[40:43], v[104:107], v[84:87], v[40:43]
    ds_read_b128 v[148:151], v193 offset:8192
    v_mfma_f32_16x16x32_bf16 v[48:51], v[104:107], v[88:91], v[48:51]
    ds_read_b64_tr_b16 v[172:173], v196 offset:0
    v_mfma_f32_16x16x32_bf16 v[48:51], v[112:115], v[92:95], v[48:51]
    ds_read_b64_tr_b16 v[174:175], v196 offset:512
    v_mfma_f32_16x16x32_bf16 v[48:51], v[120:123], v[96:99], v[48:51]
    ds_read_b64_tr_b16 v[180:181], v196 offset:1024
    v_mfma_f32_16x16x32_bf16 v[56:59], v[120:123], v[100:103], v[56:59]
    ds_read_b64_tr_b16 v[182:183], v196 offset:1536
    v_mfma_f32_16x16x32_bf16 v[56:59], v[112:115], v[96:99], v[56:59]
    s_waitcnt lgkmcnt(7)
    v_mfma_f32_16x16x32_bf16 v[56:59], v[104:107], v[92:95], v[56:59]
    v_mfma_f32_16x16x32_bf16 v[0:3], v[168:171], v[128:131], v[0:3]
    ds_read_b64_tr_b16 v[188:189], v196 offset:2048
    v_mfma_f32_16x16x32_bf16 v[0:3], v[176:179], v[132:135], v[0:3]
    ds_read_b64_tr_b16 v[190:191], v196 offset:2560
    v_mfma_f32_16x16x32_bf16 v[0:3], v[184:187], v[136:139], v[0:3]
    s_waitcnt lgkmcnt(6)
    v_mfma_f32_16x16x32_bf16 v[8:11], v[184:187], v[140:143], v[8:11]
    ds_read_b128 v[152:155], v193 offset:10240
    v_mfma_f32_16x16x32_bf16 v[8:11], v[176:179], v[136:139], v[8:11]
    ds_read_b128 v[156:159], v193 offset:12288
    v_mfma_f32_16x16x32_bf16 v[8:11], v[168:171], v[132:135], v[8:11]
    ds_read_b128 v[160:163], v193 offset:14336
    v_mfma_f32_16x16x32_bf16 v[16:19], v[168:171], v[136:139], v[16:19]
    ds_read_b128 v[164:167], v194 offset:0
    v_mfma_f32_16x16x32_bf16 v[16:19], v[176:179], v[140:143], v[16:19]
    s_add_u32 s33, s33, 1
    v_mfma_f32_16x16x32_bf16 v[16:19], v[184:187], v[144:147], v[16:19]
    s_cmp_eq_u32 s33, 3
    v_mfma_f32_16x16x32_bf16 v[24:27], v[184:187], v[148:151], v[24:27]
    s_cselect_b32 s34, 0xfffebe00, s35
    v_mfma_f32_16x16x32_bf16 v[24:27], v[176:179], v[144:147], v[24:27]
    s_waitcnt lgkmcnt(4)
    v_mfma_f32_16x16x32_bf16 v[24:27], v[168:171], v[140:143], v[24:27]
    s_cselect_b32 s33, 0, s33
    v_mfma_f32_16x16x32_bf16 v[4:7], v[172:175], v[128:131], v[4:7]
    v_add_u32 v192, s34, v192
    v_mfma_f32_16x16x32_bf16 v[4:7], v[180:183], v[132:135], v[4:7]
    v_add_u32 v193, s34, v193
    v_mfma_f32_16x16x32_bf16 v[4:7], v[188:191], v[136:139], v[4:7]
    v_add_u32 v194, s34, v194
    v_mfma_f32_16x16x32_bf16 v[12:15], v[188:191], v[140:143], v[12:15]
    v_add_u32 v195, s34, v195
    v_mfma_f32_16x16x32_bf16 v[12:15], v[180:183], v[136:139], v[12:15]
    v_add_u32 v196, s34, v196
    v_mfma_f32_16x16x32_bf16 v[12:15], v[172:175], v[132:135], v[12:15]
    s_add_u32 s30, s30, 1
    v_mfma_f32_16x16x32_bf16 v[20:23], v[172:175], v[136:139], v[20:23]
    s_cmp_lt_u32 s30, 7
    v_mfma_f32_16x16x32_bf16 v[20:23], v[180:183], v[140:143], v[20:23]
    v_mfma_f32_16x16x32_bf16 v[20:23], v[188:191], v[144:147], v[20:23]
    v_mfma_f32_16x16x32_bf16 v[28:31], v[188:191], v[148:151], v[28:31]
    v_mfma_f32_16x16x32_bf16 v[28:31], v[180:183], v[144:147], v[28:31]
    v_mfma_f32_16x16x32_bf16 v[28:31], v[172:175], v[140:143], v[28:31]
    s_waitcnt lgkmcnt(0)
    v_mfma_f32_16x16x32_bf16 v[36:39], v[172:175], v[144:147], v[36:39]
    v_mfma_f32_16x16x32_bf16 v[36:39], v[180:183], v[148:151], v[36:39]
    v_mfma_f32_16x16x32_bf16 v[36:39], v[188:191], v[152:155], v[36:39]
    v_mfma_f32_16x16x32_bf16 v[44:47], v[188:191], v[156:159], v[44:47]
    v_mfma_f32_16x16x32_bf16 v[44:47], v[180:183], v[152:155], v[44:47]
    v_mfma_f32_16x16x32_bf16 v[44:47], v[172:175], v[148:151], v[44:47]
    s_barrier
    v_mfma_f32_16x16x32_bf16 v[52:55], v[172:175], v[152:155], v[52:55]
    ds_read_b64_tr_b16 v[104:105], v195 offset:0
    v_mfma_f32_16x16x32_bf16 v[52:55], v[180:183], v[156:159], v[52:55]
    ds_read_b64_tr_b16 v[106:107], v195 offset:512
    v_mfma_f32_16x16x32_bf16 v[52:55], v[188:191], v[160:163], v[52:55]
    ds_read_b128 v[64:67], v192 offset:0
    v_mfma_f32_16x16x32_bf16 v[60:63], v[188:191], v[164:167], v[60:63]
    ds_read_b64_tr_b16 v[112:113], v195 offset:1024
    v_mfma_f32_16x16x32_bf16 v[60:63], v[180:183], v[160:163], v[60:63]
    ds_read_b64_tr_b16 v[114:115], v195 offset:1536
    v_mfma_f32_16x16x32_bf16 v[60:63], v[172:175], v[156:159], v[60:63]
    ds_read_b128 v[68:71], v193 offset:0
    v_mfma_f32_16x16x32_bf16 v[32:35], v[168:171], v[144:147], v[32:35]
    ds_read_b64_tr_b16 v[120:121], v195 offset:2048
    v_mfma_f32_16x16x32_bf16 v[32:35], v[176:179], v[148:151], v[32:35]
    ds_read_b64_tr_b16 v[122:123], v195 offset:2560
    v_mfma_f32_16x16x32_bf16 v[32:35], v[184:187], v[152:155], v[32:35]
    ds_read_b128 v[72:75], v193 offset:2048
    v_mfma_f32_16x16x32_bf16 v[40:43], v[184:187], v[156:159], v[40:43]
    ds_read_b128 v[76:79], v193 offset:4096
    v_mfma_f32_16x16x32_bf16 v[40:43], v[176:179], v[152:155], v[40:43]
    ds_read_b128 v[80:83], v193 offset:6144
    v_mfma_f32_16x16x32_bf16 v[40:43], v[168:171], v[148:151], v[40:43]
    ds_read_b128 v[84:87], v193 offset:8192
    v_mfma_f32_16x16x32_bf16 v[48:51], v[168:171], v[152:155], v[48:51]
    ds_read_b64_tr_b16 v[108:109], v196 offset:0
    v_mfma_f32_16x16x32_bf16 v[48:51], v[176:179], v[156:159], v[48:51]
    ds_read_b64_tr_b16 v[110:111], v196 offset:512
    v_mfma_f32_16x16x32_bf16 v[48:51], v[184:187], v[160:163], v[48:51]
    ds_read_b64_tr_b16 v[116:117], v196 offset:1024
    v_mfma_f32_16x16x32_bf16 v[56:59], v[184:187], v[164:167], v[56:59]
    ds_read_b64_tr_b16 v[118:119], v196 offset:1536
    v_mfma_f32_16x16x32_bf16 v[56:59], v[176:179], v[160:163], v[56:59]
    s_waitcnt lgkmcnt(7)
    v_mfma_f32_16x16x32_bf16 v[56:59], v[168:171], v[156:159], v[56:59]
    s_cbranch_scc1 L_cloop
    v_mfma_f32_16x16x32_bf16 v[0:3], v[104:107], v[64:67], v[0:3]
    ds_read_b64_tr_b16 v[124:125], v196 offset:2048
    v_mfma_f32_16x16x32_bf16 v[0:3], v[112:115], v[68:71], v[0:3]
    ds_read_b64_tr_b16 v[126:127], v196 offset:2560
    v_mfma_f32_16x16x32_bf16 v[0:3], v[120:123], v[72:75], v[0:3]
    s_waitcnt lgkmcnt(4)
    v_mfma_f32_16x16x32_bf16 v[8:11], v[120:123], v[76:79], v[8:11]
    ds_read_b128 v[88:91], v193 offset:10240
    v_mfma_f32_16x16x32_bf16 v[8:11], v[112:115], v[72:75], v[8:11]
    ds_read_b128 v[92:95], v193 offset:12288
    v_mfma_f32_16x16x32_bf16 v[8:11], v[104:107], v[68:71], v[8:11]
    ds_read_b128 v[96:99], v193 offset:14336
    v_mfma_f32_16x16x32_bf16 v[16:19], v[104:107], v[72:75], v[16:19]
    ds_read_b128 v[100:103], v194 offset:0
    v_mfma_f32_16x16x32_bf16 v[16:19], v[112:115], v[76:79], v[16:19]
    v_mfma_f32_16x16x32_bf16 v[16:19], v[120:123], v[80:83], v[16:19]
    v_mfma_f32_16x16x32_bf16 v[24:27], v[120:123], v[84:87], v[24:27]
    v_mfma_f32_16x16x32_bf16 v[24:27], v[112:115], v[80:83], v[24:27]
    v_mfma_f32_16x16x32_bf16 v[24:27], v[104:107], v[76:79], v[24:27]
    s_barrier
    v_mfma_f32_16x16x32_bf16 v[4:7], v[108:111], v[64:67], v[4:7]
    s_waitcnt lgkmcnt(1)
    v_mfma_f32_16x16x32_bf16 v[4:7], v[116:119], v[68:71], v[4:7]
    ds_read_b64_tr_b16 v[168:169], v202 offset:0
    v_mfma_f32_16x16x32_bf16 v[4:7], v[124:127], v[72:75], v[4:7]
    ds_read_b64_tr_b16 v[170:171], v202 offset:512
    v_mfma_f32_16x16x32_bf16 v[12:15], v[124:127], v[76:79], v[12:15]
    ds_read_b128 v[128:131], v199 offset:0
    v_mfma_f32_16x16x32_bf16 v[12:15], v[116:119], v[72:75], v[12:15]
    ds_read_b64_tr_b16 v[176:177], v202 offset:1024
    v_mfma_f32_16x16x32_bf16 v[12:15], v[108:111], v[68:71], v[12:15]
    ds_read_b64_tr_b16 v[178:179], v202 offset:1536
    v_mfma_f32_16x16x32_bf16 v[20:23], v[108:111], v[72:75], v[20:23]
    ds_read_b128 v[132:135], v200 offset:0
    v_mfma_f32_16x16x32_bf16 v[20:23], v[116:119], v[76:79], v[20:23]
    ds_read_b64_tr_b16 v[184:185], v202 offset:2048
    v_mfma_f32_16x16x32_bf16 v[20:23], v[124:127], v[80:83], v[20:23]
    ds_read_b64_tr_b16 v[186:187], v202 offset:2560
    v_mfma_f32_16x16x32_bf16 v[28:31], v[124:127], v[84:87], v[28:31]
    ds_read_b128 v[136:139], v200 offset:2048
    v_mfma_f32_16x16x32_bf16 v[28:31], v[116:119], v[80:83], v[28:31]
    ds_read_b128 v[140:143], v200 offset:4096
    v_mfma_f32_16x16x32_bf16 v[28:31], v[108:111], v[76:79], v[28:31]
    ds_read_b64_tr_b16 v[172:173], v203 offset:0
    v_mfma_f32_16x16x32_bf16 v[36:39], v[108:111], v[80:83], v[36:39]
    ds_read_b64_tr_b16 v[174:175], v203 offset:512
    v_mfma_f32_16x16x32_bf16 v[36:39], v[116:119], v[84:87], v[36:39]
    ds_read_b64_tr_b16 v[180:181], v203 offset:1024
    v_mfma_f32_16x16x32_bf16 v[36:39], v[124:127], v[88:91], v[36:39]
    ds_read_b64_tr_b16 v[182:183], v203 offset:1536
    v_mfma_f32_16x16x32_bf16 v[44:47], v[124:127], v[92:95], v[44:47]
    ds_read_b64_tr_b16 v[188:189], v203 offset:2048
    v_mfma_f32_16x16x32_bf16 v[44:47], v[116:119], v[88:91], v[44:47]
    ds_read_b64_tr_b16 v[190:191], v203 offset:2560
    v_mfma_f32_16x16x32_bf16 v[44:47], v[108:111], v[84:87], v[44:47]
    s_waitcnt lgkmcnt(6)
    v_mfma_f32_16x16x32_bf16 v[0:3], v[168:171], v[128:131], v[0:3]
    ds_read_b128 v[144:147], v200 offset:6144
    v_mfma_f32_16x16x32_bf16 v[0:3], v[176:179], v[132:135], v[0:3]
    ds_read_b128 v[148:151], v200 offset:8192
    v_mfma_f32_16x16x32_bf16 v[0:3], v[184:187], v[136:139], v[0:3]
    ds_read_b128 v[152:155], v200 offset:10240
    v_mfma_f32_16x16x32_bf16 v[8:11], v[184:187], v[140:143], v[8:11]
    ds_read_b128 v[156:159], v200 offset:12288
    v_mfma_f32_16x16x32_bf16 v[8:11], v[176:179], v[136:139], v[8:11]
    ds_read_b128 v[160:163], v200 offset:14336
    v_mfma_f32_16x16x32_bf16 v[8:11], v[168:171], v[132:135], v[8:11]
    s_waitcnt lgkmcnt(5)
    v_mfma_f32_16x16x32_bf16 v[12:15], v[172:175], v[132:135], v[12:15]
    ds_write_b128 v197, v[0:3] offset:0
    v_mfma_f32_16x16x32_bf16 v[12:15], v[180:183], v[136:139], v[12:15]
    s_barrier
    v_mfma_f32_16x16x32_bf16 v[12:15], v[188:191], v[140:143], v[12:15]
    ds_read_b128 v[164:167], v201 offset:0
    v_mfma_f32_16x16x32_bf16 v[4:7], v[188:191], v[136:139], v[4:7]
    ds_write_b128 v197, v[8:11] offset:4096
    v_mfma_f32_16x16x32_bf16 v[4:7], v[180:183], v[132:135], v[4:7]
    ds_read_b128 v[64:67], v212
    v_mfma_f32_16x16x32_bf16 v[4:7], v[172:175], v[128:131], v[4:7]
    ds_read_b128 v[72:75], v212 offset:256
    v_mfma_f32_16x16x32_bf16 v[20:23], v[172:175], v[136:139], v[20:23]
    ds_write_b128 v198, v[12:15] offset:4096
    v_mfma_f32_16x16x32_bf16 v[20:23], v[180:183], v[140:143], v[20:23]
    s_waitcnt lgkmcnt(5)
    v_mfma_f32_16x16x32_bf16 v[20:23], v[188:191], v[144:147], v[20:23]
    ds_read_b128 v[68:71], v212 offset:16
    v_mfma_f32_16x16x32_bf16 v[28:31], v[188:191], v[148:151], v[28:31]
    ds_write_b128 v198, v[4:7] offset:0
    v_mfma_f32_16x16x32_bf16 v[28:31], v[180:183], v[144:147], v[28:31]
    ds_read_b128 v[76:79], v212 offset:272
    v_mfma_f32_16x16x32_bf16 v[28:31], v[172:175], v[140:143], v[28:31]
    v_mfma_f32_16x16x32_bf16 v[24:27], v[168:171], v[140:143], v[24:27]
    s_waitcnt lgkmcnt(1)
    v_mfma_f32_16x16x32_bf16 v[24:27], v[176:179], v[144:147], v[24:27]
    s_barrier
    v_mfma_f32_16x16x32_bf16 v[24:27], v[184:187], v[148:151], v[24:27]
    ds_read_b128 v[0:3], v208 offset:0
    v_mfma_f32_16x16x32_bf16 v[16:19], v[184:187], v[144:147], v[16:19]
    ds_read_b128 v[8:11], v210 offset:0
    v_mfma_f32_16x16x32_bf16 v[16:19], v[176:179], v[140:143], v[16:19]
    ds_read_b128 v[4:7], v209 offset:0
    v_mfma_f32_16x16x32_bf16 v[16:19], v[168:171], v[136:139], v[16:19]
    ds_read_b128 v[12:15], v211 offset:0
    v_mfma_f32_16x16x32_bf16 v[32:35], v[104:107], v[80:83], v[32:35]
    ds_write_b128 v198, v[20:23] offset:8192
    v_mfma_f32_16x16x32_bf16 v[32:35], v[112:115], v[84:87], v[32:35]
    v_mfma_f32_16x16x32_bf16 v[32:35], v[120:123], v[88:91], v[32:35]
    v_mfma_f32_16x16x32_bf16 v[32:35], v[184:187], v[152:155], v[32:35]
    ds_write_b128 v198, v[28:31] offset:12288
    v_mfma_f32_16x16x32_bf16 v[32:35], v[176:179], v[148:151], v[32:35]
    v_mfma_f32_16x16x32_bf16 v[32:35], v[168:171], v[144:147], v[32:35]
    s_waitcnt lgkmcnt(2)
    v_mfma_f32_16x16x32_bf16 v[40:43], v[104:107], v[84:87], v[40:43]
    ds_write_b128 v197, v[24:27] offset:12288
    v_mfma_f32_16x16x32_bf16 v[40:43], v[112:115], v[88:91], v[40:43]
    v_add_f32 v0, v0, v8
    v_add_f32 v1, v1, v9
    v_mfma_f32_16x16x32_bf16 v[40:43], v[120:123], v[92:95], v[40:43]
    v_add_f32 v2, v2, v10
    v_add_f32 v3, v3, v11
    v_mfma_f32_16x16x32_bf16 v[40:43], v[184:187], v[156:159], v[40:43]
    ds_write_b128 v197, v[16:19] offset:8192
    v_mfma_f32_16x16x32_bf16 v[40:43], v[176:179], v[152:155], v[40:43]
    v_fma_f32 v0, v0, v64, v72
    v_fma_f32 v1, v1, v65, v73
    v_mfma_f32_16x16x32_bf16 v[40:43], v[168:171], v[148:151], v[40:43]
    v_add_f32 v4, v4, v12
    v_add_f32 v5, v5, v13
    v_mfma_f32_16x16x32_bf16 v[44:47], v[172:175], v[148:151], v[44:47]
    ds_write_b128 v197, v[32:35] offset:16384
    v_mfma_f32_16x16x32_bf16 v[44:47], v[180:183], v[152:155], v[44:47]
    v_fma_f32 v2, v2, v66, v74
    v_fma_f32 v3, v3, v67, v75
    v_mfma_f32_16x16x32_bf16 v[44:47], v[188:191], v[156:159], v[44:47]
    v_exp_f32 v128, v0
    v_mfma_f32_16x16x32_bf16 v[36:39], v[188:191], v[152:155], v[36:39]
    ds_write_b128 v197, v[40:43] offset:20480
    v_mfma_f32_16x16x32_bf16 v[36:39], v[180:183], v[148:151], v[36:39]
    v_add_f32 v6, v6, v14
    v_add_f32 v7, v7, v15
    v_mfma_f32_16x16x32_bf16 v[36:39], v[172:175], v[144:147], v[36:39]
    v_exp_f32 v129, v1
    v_mfma_f32_16x16x32_bf16 v[52:55], v[108:111], v[88:91], v[52:55]
    ds_write_b128 v198, v[44:47] offset:20480
    v_mfma_f32_16x16x32_bf16 v[52:55], v[116:119], v[92:95], v[52:55]
    v_fma_f32 v4, v4, v68, v76
    v_fma_f32 v5, v5, v69, v77
    v_mfma_f32_16x16x32_bf16 v[52:55], v[124:127], v[96:99], v[52:55]
    v_exp_f32 v130, v2
    v_mfma_f32_16x16x32_bf16 v[52:55], v[188:191], v[160:163], v[52:55]
    ds_write_b128 v198, v[36:39] offset:16384
    v_mfma_f32_16x16x32_bf16 v[52:55], v[180:183], v[156:159], v[52:55]
    v_fma_f32 v6, v6, v70, v78
    v_fma_f32 v7, v7, v71, v79
    v_mfma_f32_16x16x32_bf16 v[52:55], v[172:175], v[152:155], v[52:55]
    v_exp_f32 v131, v3
    v_mfma_f32_16x16x32_bf16 v[60:63], v[108:111], v[92:95], v[60:63]
    s_waitcnt lgkmcnt(0)
    v_mfma_f32_16x16x32_bf16 v[60:63], v[116:119], v[96:99], v[60:63]
    s_barrier
    v_mfma_f32_16x16x32_bf16 v[60:63], v[124:127], v[100:103], v[60:63]
    v_fma_f32 v128, v128, s26, s26
    v_fma_f32 v129, v129, s26, s26
    v_mfma_f32_16x16x32_bf16 v[60:63], v[188:191], v[164:167], v[60:63]
    ds_write_b128 v198, v[52:55] offset:24576
    v_mfma_f32_16x16x32_bf16 v[60:63], v[180:183], v[160:163], v[60:63]
    v_exp_f32 v132, v4
    v_mfma_f32_16x16x32_bf16 v[60:63], v[172:175], v[156:159], v[60:63]
    v_exp_f32 v133, v5
    v_mfma_f32_16x16x32_bf16 v[56:59], v[104:107], v[92:95], v[56:59]
    v_fma_f32 v130, v130, s26, s26
    v_fma_f32 v131, v131, s26, s26
    v_mfma_f32_16x16x32_bf16 v[56:59], v[112:115], v[96:99], v[56:59]
    v_exp_f32 v134, v6
    v_mfma_f32_16x16x32_bf16 v[56:59], v[120:123], v[100:103], v[56:59]
    v_exp_f32 v135, v7
    v_mfma_f32_16x16x32_bf16 v[56:59], v[184:187], v[164:167], v[56:59]
    ds_write_b128 v198, v[60:63] offset:28672
    v_mfma_f32_16x16x32_bf16 v[56:59], v[176:179], v[160:163], v[56:59]
    v_fma_f32 v132, v132, s26, s26
    v_fma_f32 v133, v133, s26, s26
    v_mfma_f32_16x16x32_bf16 v[56:59], v[168:171], v[156:159], v[56:59]
    v_rcp_f32 v128, v128
    v_mfma_f32_16x16x32_bf16 v[48:51], v[104:107], v[88:91], v[48:51]
    v_rcp_f32 v129, v129
    v_mfma_f32_16x16x32_bf16 v[48:51], v[112:115], v[92:95], v[48:51]
    v_fma_f32 v134, v134, s26, s26
    v_fma_f32 v135, v135, s26, s26
    v_mfma_f32_16x16x32_bf16 v[48:51], v[120:123], v[96:99], v[48:51]
    v_rcp_f32 v130, v130
    v_mfma_f32_16x16x32_bf16 v[48:51], v[184:187], v[160:163], v[48:51]
    ds_write_b128 v197, v[56:59] offset:28672
    v_mfma_f32_16x16x32_bf16 v[48:51], v[176:179], v[156:159], v[48:51]
    v_rcp_f32 v131, v131
    v_mfma_f32_16x16x32_bf16 v[48:51], v[168:171], v[152:155], v[48:51]
    v_mul_f32 v0, v0, v128
    v_mul_f32 v1, v1, v129
    v_rcp_f32 v132, v132
    v_rcp_f32 v133, v133
    v_pk_mul_f32 v[2:3], v[2:3], v[130:131]
    v_rcp_f32 v134, v134
    v_cvt_pk_bf16_f32 v216, v0, v1
    v_rcp_f32 v135, v135
    ds_write_b128 v197, v[48:51] offset:24576
    ds_write_b32 v204, v205
    v_pk_mul_f32 v[4:5], v[4:5], v[132:133]
    v_cvt_pk_bf16_f32 v217, v2, v3
    v_pk_mul_f32 v[6:7], v[6:7], v[134:135]
    v_cvt_pk_bf16_f32 v218, v4, v5
    v_cvt_pk_bf16_f32 v219, v6, v7
    buffer_store_dwordx4 v[216:219], v213, s[48:51], 0 offen sc0 sc1 nt
    s_setprio 0
L_retry:
    ds_read_b32 v215, v214
    ds_read_b128 v[80:83], v208 offset:24576
    ds_read_b128 v[88:91], v210 offset:24576
    ds_read_b128 v[84:87], v209 offset:24576
    ds_read_b128 v[92:95], v211 offset:24576
    s_waitcnt lgkmcnt(0)
    v_cmp_ne_u32 vcc, 1, v215
    s_cbranch_vccnz L_retry
    v_pk_add_f32 v[80:81], v[80:81], v[88:89]
    v_pk_add_f32 v[82:83], v[82:83], v[90:91]
    v_pk_fma_f32 v[80:81], v[80:81], v[64:65], v[72:73]
    v_pk_add_f32 v[84:85], v[84:85], v[92:93]
    v_pk_fma_f32 v[82:83], v[82:83], v[66:67], v[74:75]
    v_exp_f32 v112, v80
    v_pk_add_f32 v[86:87], v[86:87], v[94:95]
    v_exp_f32 v113, v81
    v_pk_fma_f32 v[84:85], v[84:85], v[68:69], v[76:77]
    v_exp_f32 v114, v82
    v_pk_fma_f32 v[86:87], v[86:87], v[70:71], v[78:79]
    v_exp_f32 v115, v83
    v_pk_fma_f32 v[112:113], v[112:113], s[26:27], s[26:27] op_sel_hi:[1,0,0]
    v_exp_f32 v116, v84
    v_exp_f32 v117, v85
    v_pk_fma_f32 v[114:115], v[114:115], s[26:27], s[26:27] op_sel_hi:[1,0,0]
    v_exp_f32 v118, v86
    v_exp_f32 v119, v87
    v_pk_fma_f32 v[116:117], v[116:117], s[26:27], s[26:27] op_sel_hi:[1,0,0]
    v_rcp_f32 v112, v112
    v_rcp_f32 v113, v113
    v_pk_fma_f32 v[118:119], v[118:119], s[26:27], s[26:27] op_sel_hi:[1,0,0]
    v_rcp_f32 v114, v114
    v_rcp_f32 v115, v115
    v_pk_mul_f32 v[80:81], v[80:81], v[112:113]
    v_rcp_f32 v116, v116
    v_rcp_f32 v117, v117
    v_pk_mul_f32 v[82:83], v[82:83], v[114:115]
    v_rcp_f32 v118, v118
    v_cvt_pk_bf16_f32 v120, v80, v81
    v_rcp_f32 v119, v119
    v_pk_mul_f32 v[84:85], v[84:85], v[116:117]
    v_cvt_pk_bf16_f32 v121, v82, v83
    v_pk_mul_f32 v[86:87], v[86:87], v[118:119]
    v_cvt_pk_bf16_f32 v122, v84, v85
    v_cvt_pk_bf16_f32 v123, v86, v87
    buffer_store_dwordx4 v[120:123], v213, s[48:51], s29 offen sc0 sc1 nt
    s_endpgm
    .type L_tab,@object
L_tab:
    .long 0x83120756, 0x0fedac9b
    .long 0x82310647, 0x0fecdba9
    .long 0x38217065, 0x0fdecab9
    .long 0x93201764, 0x0efdcab8
    .long 0xb1302574, 0x0dcf9ea8
    .long 0xb0132465, 0x0dcef89a
    .long 0x1b035247, 0x0dfce98a
    .long 0xa1023546, 0x0cdfe98b
    .size L_tab, 64
L_pad:
    .fill (8448 - (. - L_pc)) / 4, 4, 0xbf810000

.section .rodata,"a"
.p2align 6
.amdhsa_kernel standalone__batchnorm__prompt_kernel
  .amdhsa_next_free_vgpr 224
  .amdhsa_next_free_sgpr 102
  .amdhsa_accum_offset 224
  .amdhsa_group_segment_fixed_size 0
  .amdhsa_kernarg_size 72
  .amdhsa_user_sgpr_count 2
  .amdhsa_user_sgpr_kernarg_segment_ptr 1
  .amdhsa_system_sgpr_workgroup_id_x 1
.end_amdhsa_kernel
```
